```python
import torch

def _softmax(x, axis=-1):
    return torch.softmax(x, dim=axis)
def _gelu(x):
    return torch.nn.functional.gelu(x, approximate="tanh")
def _silu(x):
    return torch.nn.functional.silu(x)
def _sigmoid(x):
    return torch.sigmoid(x)
def _layernorm(x, axis=-1, eps=1e-5):
    m = x.mean(dim=axis, keepdim=True)
    v = x.var(dim=axis, keepdim=True, unbiased=False)
    return (x - m) / torch.sqrt(v + eps)
def _scatter_add(tgt, idx, src, axis=0):
    return tgt.clone().index_add_(axis, idx, src)
def _segment_sum(src, seg, n):
    out = torch.zeros((n,) + src.shape[1:], dtype=src.dtype)
    return out.index_add_(0, seg, src)
def _pad(x, pw):
    flat = tuple(v for pair in reversed(pw) for v in pair)
    return torch.nn.functional.pad(x, flat)

kernel_name = 'standalone__sliding_local_strided__prompt'

def setup_inputs():

    _w = (lambda a: (lambda t: t.to(torch.bfloat16) if t.is_floating_point() else t)(torch.as_tensor(a)))
    B, H, S, D = 1, 32, 2048, 128
    return {
        "q": _w((lambda *s: torch.randn(*s, dtype=torch.bfloat16) * 0.8)(B, H, S, D)),
        "k": _w((lambda *s: torch.randn(*s, dtype=torch.bfloat16) * 0.8)(B, H, S, D)),
        "v": _w((lambda *s: torch.randn(*s, dtype=torch.bfloat16) * 0.05)(B, H, S, D)),
    }

def reference(q, k, v):
    B, H, S, D = q.shape
    W, dil = 8, 4
    scale = D ** -0.5
    pos = torch.arange(S)
    kidx = pos[:, None] - torch.arange(W)[None, :] * dil
    valid = kidx >= 0
    kidx = torch.where(valid, kidx, torch.zeros_like(kidx))
    idx = torch.reshape(kidx, (1, 1, S * W, 1))
    idx = (lambda x, n, axis: torch.repeat_interleave(x, n, dim=axis))(idx, B, 0)
    idx = (lambda x, n, axis: torch.repeat_interleave(x, n, dim=axis))(idx, H, 1)
    idx = (lambda x, n, axis: torch.repeat_interleave(x, n, dim=axis))(idx, D, 3)
    kg = torch.reshape((lambda x, i, axis: torch.take_along_dim(x, i, dim=axis))(k, idx, 2), (B, H, S, W, D))
    vg = torch.reshape((lambda x, i, axis: torch.take_along_dim(x, i, dim=axis))(v, idx, 2), (B, H, S, W, D))
    scores = torch.einsum("bhsd,bhswd->bhsw", q, kg) * scale
    mask_f = (lambda x, dt: x.to(dt))(valid, q.dtype)[None, None, :, :]
    scores = scores + (mask_f - 1.0) * 1e9
    p = _softmax(scores, axis=-1)
    return torch.einsum("bhsw,bhswd->bhsd", p, vg)
```

```asm
; @launch grid=(256,1,1) block=(256,1,1) lds=139264
.amdgcn_target "amdgcn-amd-amdhsa--gfx950"
.text
.globl standalone__sliding_local_strided__prompt_kernel
.p2align 8
.type standalone__sliding_local_strided__prompt_kernel,@function
standalone__sliding_local_strided__prompt_kernel:
    s_load_dwordx2 s[12:13], s[0:1], 8
    s_load_dwordx2 s[8:9], s[0:1], 0
    s_load_dwordx2 s[16:17], s[0:1], 16
    s_load_dwordx2 s[20:21], s[0:1], 24
    s_cmp_ge_u32 s2, 256
    s_cbranch_scc1 L_done
    v_lshrrev_b32 v74, 6, v0
    v_and_b32 v0, 63, v0
    v_readfirstlane_b32 s47, v74
    s_mov_b32 s10, 0x1000000
    s_mov_b32 s11, 0x20000
    s_mov_b32 s14, 0x1000000
    s_mov_b32 s15, 0x20000
    s_mov_b32 s18, 0x1000000
    s_mov_b32 s19, 0x20000
    s_mov_b32 s22, 0x1000000
    s_mov_b32 s23, 0x20000
    s_and_b32 s3, s2, 7
    s_lshr_b32 s46, s2, 3
    s_lshl_b32 s3, s3, 5
    s_add_u32 s46, s46, s3
    v_lshrrev_b32 v72, 4, v0
    v_and_b32 v73, 15, v0
    v_lshlrev_b32 v74, 10, v72
    v_lshl_add_u32 v5, v73, 4, v74
    v_add_u32 v6, 4096, v5
    v_add_u32 v7, 8192, v5
    v_add_u32 v8, 12288, v5
    v_lshlrev_b32 v75, 6, v72
    v_lshl_add_u32 v75, v72, 12, v75
    v_lshlrev_b32 v74, 4, v73
    v_xor_b32 v1, v75, v74
    v_and_b32 v75, 1, v72
    v_or_b32 v75, 2, v75
    v_mul_u32_u24 v75, 4160, v75
    v_xor_b32 v75, v75, v74
    v_lshrrev_b32 v74, 1, v72
    v_lshl_add_u32 v9, v74, 10, v75
    v_add_u32 v10, 2048, v9
    s_mul_i32 s36, s47, 34816
    s_lshl_b32 s3, s47, 8
    s_lshl_b32 s24, s46, 16
    s_add_u32 s26, s24, s3
    s_sub_u32 s25, s26, 16384
    s_and_b32 s4, s46, 7
    s_cselect_b32 s25, s25, s24
    s_cselect_b32 s30, 0, 0xce6e0000
    s_cselect_b32 s5, -1, 0xff
    s_add_u32 s27, s26, 16384
    s_add_u32 s28, s26, 32768
    s_add_u32 s29, s26, 49152
    v_and_b32 v9, s5, v9
    v_and_b32 v11, s5, v7
    v_and_b32 v10, s5, v10
    v_and_b32 v12, s5, v8
    s_mov_b32 s37, 0
    s_bfe_u32 s3, s47, 0x10001
    s_lshl_b32 s3, s3, 0
    s_or_b32 s37, s37, s3
    s_bfe_u32 s3, s47, 0x10000
    s_lshl_b32 s3, s3, 1
    s_or_b32 s37, s37, s3
    s_add_u32 m0, s36, 18432
    s_cmp_eq_u32 s37, 1
    s_cbranch_scc1 L_var0_1
    s_cmp_eq_u32 s37, 2
    s_cbranch_scc1 L_var0_2
    s_cmp_eq_u32 s37, 3
    s_cbranch_scc1 L_var0_3
    s_waitcnt lgkmcnt(0)
    buffer_load_dwordx4 v1, s[12:15], s26 offen nt lds
    buffer_load_dwordx4 v1, s[12:15], s26 offen offset:1024 nt lds
    buffer_load_dwordx4 v1, s[12:15], s26 offen offset:2048 nt lds
    buffer_load_dwordx4 v1, s[12:15], s26 offen offset:3072 nt lds
    s_add_u32 m0, s36, 22528
    s_nop 0
    buffer_load_dwordx4 v1, s[12:15], s27 offen nt lds
    buffer_load_dwordx4 v1, s[12:15], s27 offen offset:1024 nt lds
    buffer_load_dwordx4 v1, s[12:15], s27 offen offset:2048 nt lds
    buffer_load_dwordx4 v1, s[12:15], s27 offen offset:3072 nt lds
    s_add_u32 m0, s36, 26624
    s_nop 0
    buffer_load_dwordx4 v1, s[12:15], s28 offen nt lds
    buffer_load_dwordx4 v1, s[12:15], s28 offen offset:1024 nt lds
    buffer_load_dwordx4 v1, s[12:15], s28 offen offset:2048 nt lds
    buffer_load_dwordx4 v1, s[12:15], s28 offen offset:3072 nt lds
    s_add_u32 m0, s36, 30720
    s_nop 0
    buffer_load_dwordx4 v1, s[12:15], s29 offen nt lds
    buffer_load_dwordx4 v1, s[12:15], s29 offen offset:1024 nt lds
    buffer_load_dwordx4 v1, s[12:15], s29 offen offset:2048 nt lds
    buffer_load_dwordx4 v1, s[12:15], s29 offen offset:3072 nt lds
    s_add_u32 m0, s36, 16384
    s_nop 0
    buffer_load_dwordx4 v9, s[12:15], s25 offen nt lds
    s_add_u32 m0, s36, 17408
    s_nop 0
    buffer_load_dwordx4 v10, s[12:15], s25 offen nt lds
    s_add_u32 m0, s36, 0
    s_nop 0
    buffer_load_dwordx4 v1, s[8:11], s26 offen nt lds
    buffer_load_dwordx4 v1, s[8:11], s26 offen offset:1024 nt lds
    buffer_load_dwordx4 v1, s[8:11], s26 offen offset:2048 nt lds
    buffer_load_dwordx4 v1, s[8:11], s26 offen offset:3072 nt lds
    s_add_u32 m0, s36, 4096
    s_nop 0
    buffer_load_dwordx4 v1, s[8:11], s27 offen nt lds
    buffer_load_dwordx4 v1, s[8:11], s27 offen offset:1024 nt lds
    buffer_load_dwordx4 v1, s[8:11], s27 offen offset:2048 nt lds
    buffer_load_dwordx4 v1, s[8:11], s27 offen offset:3072 nt lds
    s_add_u32 m0, s36, 8192
    s_nop 0
    buffer_load_dwordx4 v1, s[8:11], s28 offen nt lds
    buffer_load_dwordx4 v1, s[8:11], s28 offen offset:1024 nt lds
    buffer_load_dwordx4 v1, s[8:11], s28 offen offset:2048 nt lds
    buffer_load_dwordx4 v1, s[8:11], s28 offen offset:3072 nt lds
    s_add_u32 m0, s36, 12288
    s_nop 0
    buffer_load_dwordx4 v1, s[8:11], s29 offen nt lds
    buffer_load_dwordx4 v1, s[8:11], s29 offen offset:1024 nt lds
    buffer_load_dwordx4 v1, s[8:11], s29 offen offset:2048 nt lds
    buffer_load_dwordx4 v1, s[8:11], s29 offen offset:3072 nt lds
    buffer_load_dwordx4 v[136:139], v11, s[16:19], s25 offen nt
    buffer_load_dwordx4 v[140:143], v12, s[16:19], s25 offen nt
    buffer_load_dwordx4 v[144:147], v5, s[16:19], s26 offen nt
    buffer_load_dwordx4 v[148:151], v6, s[16:19], s26 offen nt
    buffer_load_dwordx4 v[152:155], v7, s[16:19], s26 offen nt
    buffer_load_dwordx4 v[156:159], v8, s[16:19], s26 offen nt
    buffer_load_dwordx4 v[160:163], v5, s[16:19], s27 offen nt
    buffer_load_dwordx4 v[164:167], v6, s[16:19], s27 offen nt
    buffer_load_dwordx4 v[168:171], v7, s[16:19], s27 offen nt
    buffer_load_dwordx4 v[172:175], v8, s[16:19], s27 offen nt
    buffer_load_dwordx4 v[176:179], v5, s[16:19], s28 offen nt
    buffer_load_dwordx4 v[180:183], v6, s[16:19], s28 offen nt
    buffer_load_dwordx4 v[184:187], v7, s[16:19], s28 offen nt
    buffer_load_dwordx4 v[188:191], v8, s[16:19], s28 offen nt
    buffer_load_dwordx4 v[192:195], v5, s[16:19], s29 offen nt
    buffer_load_dwordx4 v[196:199], v6, s[16:19], s29 offen nt
    buffer_load_dwordx4 v[200:203], v7, s[16:19], s29 offen nt
    buffer_load_dwordx4 v[204:207], v8, s[16:19], s29 offen nt
    s_branch L_var0_end
L_var0_1:
    s_waitcnt lgkmcnt(0)
    buffer_load_dwordx4 v1, s[12:15], s26 offen offset:1024 nt lds
    buffer_load_dwordx4 v1, s[12:15], s26 offen nt lds
    buffer_load_dwordx4 v1, s[12:15], s26 offen offset:3072 nt lds
    buffer_load_dwordx4 v1, s[12:15], s26 offen offset:2048 nt lds
    s_add_u32 m0, s36, 22528
    s_nop 0
    buffer_load_dwordx4 v1, s[12:15], s27 offen offset:1024 nt lds
    buffer_load_dwordx4 v1, s[12:15], s27 offen nt lds
    buffer_load_dwordx4 v1, s[12:15], s27 offen offset:3072 nt lds
    buffer_load_dwordx4 v1, s[12:15], s27 offen offset:2048 nt lds
    s_add_u32 m0, s36, 26624
    s_nop 0
    buffer_load_dwordx4 v1, s[12:15], s28 offen offset:1024 nt lds
    buffer_load_dwordx4 v1, s[12:15], s28 offen nt lds
    buffer_load_dwordx4 v1, s[12:15], s28 offen offset:3072 nt lds
    buffer_load_dwordx4 v1, s[12:15], s28 offen offset:2048 nt lds
    s_add_u32 m0, s36, 30720
    s_nop 0
    buffer_load_dwordx4 v1, s[12:15], s29 offen offset:1024 nt lds
    buffer_load_dwordx4 v1, s[12:15], s29 offen nt lds
    buffer_load_dwordx4 v1, s[12:15], s29 offen offset:3072 nt lds
    buffer_load_dwordx4 v1, s[12:15], s29 offen offset:2048 nt lds
    s_add_u32 m0, s36, 16384
    s_nop 0
    buffer_load_dwordx4 v9, s[12:15], s25 offen nt lds
    s_add_u32 m0, s36, 17408
    s_nop 0
    buffer_load_dwordx4 v10, s[12:15], s25 offen nt lds
    s_add_u32 m0, s36, 0
    s_nop 0
    buffer_load_dwordx4 v1, s[8:11], s26 offen offset:1024 nt lds
    buffer_load_dwordx4 v1, s[8:11], s26 offen nt lds
    buffer_load_dwordx4 v1, s[8:11], s26 offen offset:3072 nt lds
    buffer_load_dwordx4 v1, s[8:11], s26 offen offset:2048 nt lds
    s_add_u32 m0, s36, 4096
    s_nop 0
    buffer_load_dwordx4 v1, s[8:11], s27 offen offset:1024 nt lds
    buffer_load_dwordx4 v1, s[8:11], s27 offen nt lds
    buffer_load_dwordx4 v1, s[8:11], s27 offen offset:3072 nt lds
    buffer_load_dwordx4 v1, s[8:11], s27 offen offset:2048 nt lds
    s_add_u32 m0, s36, 8192
    s_nop 0
    buffer_load_dwordx4 v1, s[8:11], s28 offen offset:1024 nt lds
    buffer_load_dwordx4 v1, s[8:11], s28 offen nt lds
    buffer_load_dwordx4 v1, s[8:11], s28 offen offset:3072 nt lds
    buffer_load_dwordx4 v1, s[8:11], s28 offen offset:2048 nt lds
    s_add_u32 m0, s36, 12288
    s_nop 0
    buffer_load_dwordx4 v1, s[8:11], s29 offen offset:1024 nt lds
    buffer_load_dwordx4 v1, s[8:11], s29 offen nt lds
    buffer_load_dwordx4 v1, s[8:11], s29 offen offset:3072 nt lds
    buffer_load_dwordx4 v1, s[8:11], s29 offen offset:2048 nt lds
    buffer_load_dwordx4 v[136:139], v11, s[16:19], s25 offen nt
    buffer_load_dwordx4 v[140:143], v12, s[16:19], s25 offen nt
    buffer_load_dwordx4 v[148:151], v6, s[16:19], s26 offen nt
    buffer_load_dwordx4 v[144:147], v5, s[16:19], s26 offen nt
    buffer_load_dwordx4 v[156:159], v8, s[16:19], s26 offen nt
    buffer_load_dwordx4 v[152:155], v7, s[16:19], s26 offen nt
    buffer_load_dwordx4 v[164:167], v6, s[16:19], s27 offen nt
    buffer_load_dwordx4 v[160:163], v5, s[16:19], s27 offen nt
    buffer_load_dwordx4 v[172:175], v8, s[16:19], s27 offen nt
    buffer_load_dwordx4 v[168:171], v7, s[16:19], s27 offen nt
    buffer_load_dwordx4 v[180:183], v6, s[16:19], s28 offen nt
    buffer_load_dwordx4 v[176:179], v5, s[16:19], s28 offen nt
    buffer_load_dwordx4 v[188:191], v8, s[16:19], s28 offen nt
    buffer_load_dwordx4 v[184:187], v7, s[16:19], s28 offen nt
    buffer_load_dwordx4 v[196:199], v6, s[16:19], s29 offen nt
    buffer_load_dwordx4 v[192:195], v5, s[16:19], s29 offen nt
    buffer_load_dwordx4 v[204:207], v8, s[16:19], s29 offen nt
    buffer_load_dwordx4 v[200:203], v7, s[16:19], s29 offen nt
    s_branch L_var0_end
L_var0_2:
    s_waitcnt lgkmcnt(0)
    buffer_load_dwordx4 v1, s[12:15], s26 offen offset:2048 nt lds
    buffer_load_dwordx4 v1, s[12:15], s26 offen offset:3072 nt lds
    buffer_load_dwordx4 v1, s[12:15], s26 offen nt lds
    buffer_load_dwordx4 v1, s[12:15], s26 offen offset:1024 nt lds
    s_add_u32 m0, s36, 22528
    s_nop 0
    buffer_load_dwordx4 v1, s[12:15], s27 offen offset:2048 nt lds
    buffer_load_dwordx4 v1, s[12:15], s27 offen offset:3072 nt lds
    buffer_load_dwordx4 v1, s[12:15], s27 offen nt lds
    buffer_load_dwordx4 v1, s[12:15], s27 offen offset:1024 nt lds
    s_add_u32 m0, s36, 26624
    s_nop 0
    buffer_load_dwordx4 v1, s[12:15], s28 offen offset:2048 nt lds
    buffer_load_dwordx4 v1, s[12:15], s28 offen offset:3072 nt lds
    buffer_load_dwordx4 v1, s[12:15], s28 offen nt lds
    buffer_load_dwordx4 v1, s[12:15], s28 offen offset:1024 nt lds
    s_add_u32 m0, s36, 30720
    s_nop 0
    buffer_load_dwordx4 v1, s[12:15], s29 offen offset:2048 nt lds
    buffer_load_dwordx4 v1, s[12:15], s29 offen offset:3072 nt lds
    buffer_load_dwordx4 v1, s[12:15], s29 offen nt lds
    buffer_load_dwordx4 v1, s[12:15], s29 offen offset:1024 nt lds
    s_add_u32 m0, s36, 16384
    s_nop 0
    buffer_load_dwordx4 v9, s[12:15], s25 offen nt lds
    s_add_u32 m0, s36, 17408
    s_nop 0
    buffer_load_dwordx4 v10, s[12:15], s25 offen nt lds
    s_add_u32 m0, s36, 0
    s_nop 0
    buffer_load_dwordx4 v1, s[8:11], s26 offen offset:2048 nt lds
    buffer_load_dwordx4 v1, s[8:11], s26 offen offset:3072 nt lds
    buffer_load_dwordx4 v1, s[8:11], s26 offen nt lds
    buffer_load_dwordx4 v1, s[8:11], s26 offen offset:1024 nt lds
    s_add_u32 m0, s36, 4096
    s_nop 0
    buffer_load_dwordx4 v1, s[8:11], s27 offen offset:2048 nt lds
    buffer_load_dwordx4 v1, s[8:11], s27 offen offset:3072 nt lds
    buffer_load_dwordx4 v1, s[8:11], s27 offen nt lds
    buffer_load_dwordx4 v1, s[8:11], s27 offen offset:1024 nt lds
    s_add_u32 m0, s36, 8192
    s_nop 0
    buffer_load_dwordx4 v1, s[8:11], s28 offen offset:2048 nt lds
    buffer_load_dwordx4 v1, s[8:11], s28 offen offset:3072 nt lds
    buffer_load_dwordx4 v1, s[8:11], s28 offen nt lds
    buffer_load_dwordx4 v1, s[8:11], s28 offen offset:1024 nt lds
    s_add_u32 m0, s36, 12288
    s_nop 0
    buffer_load_dwordx4 v1, s[8:11], s29 offen offset:2048 nt lds
    buffer_load_dwordx4 v1, s[8:11], s29 offen offset:3072 nt lds
    buffer_load_dwordx4 v1, s[8:11], s29 offen nt lds
    buffer_load_dwordx4 v1, s[8:11], s29 offen offset:1024 nt lds
    buffer_load_dwordx4 v[136:139], v11, s[16:19], s25 offen nt
    buffer_load_dwordx4 v[140:143], v12, s[16:19], s25 offen nt
    buffer_load_dwordx4 v[152:155], v7, s[16:19], s26 offen nt
    buffer_load_dwordx4 v[156:159], v8, s[16:19], s26 offen nt
    buffer_load_dwordx4 v[144:147], v5, s[16:19], s26 offen nt
    buffer_load_dwordx4 v[148:151], v6, s[16:19], s26 offen nt
    buffer_load_dwordx4 v[168:171], v7, s[16:19], s27 offen nt
    buffer_load_dwordx4 v[172:175], v8, s[16:19], s27 offen nt
    buffer_load_dwordx4 v[160:163], v5, s[16:19], s27 offen nt
    buffer_load_dwordx4 v[164:167], v6, s[16:19], s27 offen nt
    buffer_load_dwordx4 v[184:187], v7, s[16:19], s28 offen nt
    buffer_load_dwordx4 v[188:191], v8, s[16:19], s28 offen nt
    buffer_load_dwordx4 v[176:179], v5, s[16:19], s28 offen nt
    buffer_load_dwordx4 v[180:183], v6, s[16:19], s28 offen nt
    buffer_load_dwordx4 v[200:203], v7, s[16:19], s29 offen nt
    buffer_load_dwordx4 v[204:207], v8, s[16:19], s29 offen nt
    buffer_load_dwordx4 v[192:195], v5, s[16:19], s29 offen nt
    buffer_load_dwordx4 v[196:199], v6, s[16:19], s29 offen nt
    s_branch L_var0_end
L_var0_3:
    s_waitcnt lgkmcnt(0)
    buffer_load_dwordx4 v1, s[12:15], s26 offen offset:3072 nt lds
    buffer_load_dwordx4 v1, s[12:15], s26 offen offset:2048 nt lds
    buffer_load_dwordx4 v1, s[12:15], s26 offen offset:1024 nt lds
    buffer_load_dwordx4 v1, s[12:15], s26 offen nt lds
    s_add_u32 m0, s36, 22528
    s_nop 0
    buffer_load_dwordx4 v1, s[12:15], s27 offen offset:3072 nt lds
    buffer_load_dwordx4 v1, s[12:15], s27 offen offset:2048 nt lds
    buffer_load_dwordx4 v1, s[12:15], s27 offen offset:1024 nt lds
    buffer_load_dwordx4 v1, s[12:15], s27 offen nt lds
    s_add_u32 m0, s36, 26624
    s_nop 0
    buffer_load_dwordx4 v1, s[12:15], s28 offen offset:3072 nt lds
    buffer_load_dwordx4 v1, s[12:15], s28 offen offset:2048 nt lds
    buffer_load_dwordx4 v1, s[12:15], s28 offen offset:1024 nt lds
    buffer_load_dwordx4 v1, s[12:15], s28 offen nt lds
    s_add_u32 m0, s36, 30720
    s_nop 0
    buffer_load_dwordx4 v1, s[12:15], s29 offen offset:3072 nt lds
    buffer_load_dwordx4 v1, s[12:15], s29 offen offset:2048 nt lds
    buffer_load_dwordx4 v1, s[12:15], s29 offen offset:1024 nt lds
    buffer_load_dwordx4 v1, s[12:15], s29 offen nt lds
    s_add_u32 m0, s36, 16384
    s_nop 0
    buffer_load_dwordx4 v9, s[12:15], s25 offen nt lds
    s_add_u32 m0, s36, 17408
    s_nop 0
    buffer_load_dwordx4 v10, s[12:15], s25 offen nt lds
    s_add_u32 m0, s36, 0
    s_nop 0
    buffer_load_dwordx4 v1, s[8:11], s26 offen offset:3072 nt lds
    buffer_load_dwordx4 v1, s[8:11], s26 offen offset:2048 nt lds
    buffer_load_dwordx4 v1, s[8:11], s26 offen offset:1024 nt lds
    buffer_load_dwordx4 v1, s[8:11], s26 offen nt lds
    s_add_u32 m0, s36, 4096
    s_nop 0
    buffer_load_dwordx4 v1, s[8:11], s27 offen offset:3072 nt lds
    buffer_load_dwordx4 v1, s[8:11], s27 offen offset:2048 nt lds
    buffer_load_dwordx4 v1, s[8:11], s27 offen offset:1024 nt lds
    buffer_load_dwordx4 v1, s[8:11], s27 offen nt lds
    s_add_u32 m0, s36, 8192
    s_nop 0
    buffer_load_dwordx4 v1, s[8:11], s28 offen offset:3072 nt lds
    buffer_load_dwordx4 v1, s[8:11], s28 offen offset:2048 nt lds
    buffer_load_dwordx4 v1, s[8:11], s28 offen offset:1024 nt lds
    buffer_load_dwordx4 v1, s[8:11], s28 offen nt lds
    s_add_u32 m0, s36, 12288
    s_nop 0
    buffer_load_dwordx4 v1, s[8:11], s29 offen offset:3072 nt lds
    buffer_load_dwordx4 v1, s[8:11], s29 offen offset:2048 nt lds
    buffer_load_dwordx4 v1, s[8:11], s29 offen offset:1024 nt lds
    buffer_load_dwordx4 v1, s[8:11], s29 offen nt lds
    buffer_load_dwordx4 v[136:139], v11, s[16:19], s25 offen nt
    buffer_load_dwordx4 v[140:143], v12, s[16:19], s25 offen nt
    buffer_load_dwordx4 v[156:159], v8, s[16:19], s26 offen nt
    buffer_load_dwordx4 v[152:155], v7, s[16:19], s26 offen nt
    buffer_load_dwordx4 v[148:151], v6, s[16:19], s26 offen nt
    buffer_load_dwordx4 v[144:147], v5, s[16:19], s26 offen nt
    buffer_load_dwordx4 v[172:175], v8, s[16:19], s27 offen nt
    buffer_load_dwordx4 v[168:171], v7, s[16:19], s27 offen nt
    buffer_load_dwordx4 v[164:167], v6, s[16:19], s27 offen nt
    buffer_load_dwordx4 v[160:163], v5, s[16:19], s27 offen nt
    buffer_load_dwordx4 v[188:191], v8, s[16:19], s28 offen nt
    buffer_load_dwordx4 v[184:187], v7, s[16:19], s28 offen nt
    buffer_load_dwordx4 v[180:183], v6, s[16:19], s28 offen nt
    buffer_load_dwordx4 v[176:179], v5, s[16:19], s28 offen nt
    buffer_load_dwordx4 v[204:207], v8, s[16:19], s29 offen nt
    buffer_load_dwordx4 v[200:203], v7, s[16:19], s29 offen nt
    buffer_load_dwordx4 v[196:199], v6, s[16:19], s29 offen nt
    buffer_load_dwordx4 v[192:195], v5, s[16:19], s29 offen nt
L_var0_end:
    v_lshrrev_b32 v72, 4, v0
    v_and_b32 v73, 15, v0
    v_lshrrev_b32 v74, 2, v73
    v_and_b32 v75, 3, v73
    v_lshrrev_b32 v2, 1, v75
    v_add_u32 v2, v2, v74
    v_lshlrev_b32 v2, 9, v2
    v_lshlrev_b32 v74, 8, v73
    v_add_u32 v74, s36, v74
    v_lshl_add_u32 v72, v75, 2, v72
    v_lshlrev_b32 v72, 4, v72
    v_add_u32 v13, v72, v74
    v_xor_b32 v73, 64, v72
    v_add_u32 v14, v73, v74
    v_xor_b32 v73, 128, v72
    v_add_u32 v15, v73, v74
    v_xor_b32 v73, 192, v72
    v_add_u32 v16, v73, v74
    s_mov_b32 s40, 0x05040100
    s_mov_b32 s41, 0x07060302
    s_mov_b32 s42, 0x3db504f3
    s_mov_b32 s44, 0x3fb8aa3b
    s_mov_b32 s45, 0x3fb8aa3b
    s_mov_b32 s43, 0xffff0000
    v_mov_b32 v19, 0x7060504
    v_mov_b32 v20, 0x1000c0c
    v_mov_b32 v21, 0x3020c0c
    v_mov_b32 v22, 0xc0c0c0c
    v_mov_b32 v23, 0x3020100
    v_mov_b32 v24, 0xc0c0c0c
    v_mov_b32 v25, 0
    v_mov_b32 v26, 0
    v_mov_b32 v42, 0
    v_mov_b32 v46, 0
    v_mov_b32 v50, 0
    v_mov_b32 v54, 0
    v_mov_b32 v58, 0
    v_mov_b32 v62, 0
    v_mov_b32 v66, 0
    v_mov_b32 v70, 0
    v_mov_b32 v34, 0
    v_mov_b32 v36, 0
    s_mov_b32 exec_lo, 0x10000
    s_mov_b32 exec_hi, 0x1110011
    v_mov_b32 v19, 0x3020100
    v_mov_b32 v22, 0x3020100
    v_mov_b32 v23, 0xc0c0c0c
    v_mov_b32 v25, s30
    v_mov_b32 v26, s30
    s_mov_b32 exec_lo, 0x11121111
    s_mov_b32 exec_hi, 0x12221122
    v_mov_b32 v19, 0x5040302
    v_mov_b32 v22, 0x1000c0c
    v_mov_b32 v23, 0xc0c0302
    v_mov_b32 v25, s30
    s_mov_b32 exec_lo, 0x44484444
    s_mov_b32 exec_hi, 0x48884488
    v_mov_b32 v19, 0x7060706
    v_mov_b32 v21, 0x5040c0c
    v_mov_b32 v23, 0x1000c0c
    v_mov_b32 v24, 0xc0c0302
    s_mov_b32 exec_lo, 0x88808888
    s_mov_b32 exec_hi, 0x80008800
    v_mov_b32 v19, 0x7060706
    v_mov_b32 v20, 0x5040c0c
    v_mov_b32 v21, 0x7060c0c
    v_mov_b32 v23, 0xc0c0c0c
    v_mov_b32 v24, 0x3020100
    s_mov_b64 exec, -1
    s_waitcnt vmcnt(34)
    v_sub_u32 v72, v13, v2
    ds_read_b128 a[0:3], v72 offset:16384
    v_sub_u32 v73, v14, v2
    ds_read_b128 a[4:7], v73 offset:16384
    v_sub_u32 v74, v15, v2
    ds_read_b128 a[8:11], v74 offset:16384
    v_sub_u32 v75, v16, v2
    ds_read_b128 a[12:15], v75 offset:16384
    ds_read_b128 a[16:19], v13 offset:18432
    ds_read_b128 a[20:23], v14 offset:18432
    ds_read_b128 a[24:27], v15 offset:18432
    ds_read_b128 a[28:31], v16 offset:18432
    ds_read_b128 a[32:35], v13 offset:22528
    ds_read_b128 a[36:39], v14 offset:22528
    ds_read_b128 a[40:43], v15 offset:22528
    ds_read_b128 a[44:47], v16 offset:22528
    s_waitcnt lgkmcnt(4)
    ds_read_b128 a[48:51], v13 offset:26624
    ds_read_b128 a[52:55], v14 offset:26624
    ds_read_b128 a[56:59], v15 offset:26624
    ds_read_b128 a[60:63], v16 offset:26624
    ds_read_b128 a[64:67], v13 offset:30720
    ds_read_b128 a[68:71], v14 offset:30720
    ds_read_b128 a[72:75], v15 offset:30720
    ds_read_b128 a[76:79], v16 offset:30720
    s_waitcnt vmcnt(30)
    s_waitcnt lgkmcnt(8)
    ds_read_b128 a[80:83], v13 offset:0
    ds_read_b128 a[84:87], v14 offset:0
    ds_read_b128 a[88:91], v15 offset:0
    ds_read_b128 a[92:95], v16 offset:0
    s_waitcnt lgkmcnt(3)
    v_mfma_f32_16x16x32_bf16 v[104:107], a[0:3], a[80:83], 0
    v_mfma_f32_16x16x32_bf16 v[108:111], a[16:19], a[80:83], 0
    s_waitcnt lgkmcnt(2)
    v_mfma_f32_16x16x32_bf16 v[104:107], a[4:7], a[84:87], v[104:107]
    v_mfma_f32_16x16x32_bf16 v[108:111], a[20:23], a[84:87], v[108:111]
    s_waitcnt lgkmcnt(1)
    v_mfma_f32_16x16x32_bf16 v[104:107], a[8:11], a[88:91], v[104:107]
    v_mfma_f32_16x16x32_bf16 v[108:111], a[24:27], a[88:91], v[108:111]
    s_waitcnt lgkmcnt(0)
    v_mfma_f32_16x16x32_bf16 v[104:107], a[12:15], a[92:95], v[104:107]
    v_mfma_f32_16x16x32_bf16 v[108:111], a[28:31], a[92:95], v[108:111]
    s_waitcnt vmcnt(26)
    ds_read_b128 a[96:99], v13 offset:4096
    ds_read_b128 a[100:103], v14 offset:4096
    ds_read_b128 a[104:107], v15 offset:4096
    ds_read_b128 a[108:111], v16 offset:4096
    s_nop 2
    v_cvt_pk_bf16_f32 v72, v106, v107
    v_cvt_pk_bf16_f32 v76, v108, v109
    v_cvt_pk_bf16_f32 v80, v110, v111
    v_perm_b32 v72, v76, v72, v19
    v_perm_b32 v84, v80, v72, v20
    v_perm_b32 v85, v80, v72, v21
    v_mul_f32 v84, s42, v84
    v_mul_f32 v85, s42, v85
    v_cvt_pk_bf16_f32 v28, v84, v85
    v_lshlrev_b32 v84, 16, v28
    v_and_b32 v85, s43, v28
    v_add_f32 v84, v84, v25
    v_add_f32 v85, v85, v26
    v_cvt_pk_bf16_f32 v28, v84, v85
    s_waitcnt lgkmcnt(3)
    v_mfma_f32_16x16x32_bf16 v[112:115], a[16:19], a[96:99], 0
    v_mfma_f32_16x16x32_bf16 v[116:119], a[32:35], a[96:99], 0
    s_waitcnt lgkmcnt(2)
    v_mfma_f32_16x16x32_bf16 v[112:115], a[20:23], a[100:103], v[112:115]
    v_mfma_f32_16x16x32_bf16 v[116:119], a[36:39], a[100:103], v[116:119]
    s_waitcnt lgkmcnt(1)
    v_mfma_f32_16x16x32_bf16 v[112:115], a[24:27], a[104:107], v[112:115]
    v_mfma_f32_16x16x32_bf16 v[116:119], a[40:43], a[104:107], v[116:119]
    s_waitcnt lgkmcnt(0)
    v_mfma_f32_16x16x32_bf16 v[112:115], a[28:31], a[108:111], v[112:115]
    v_mfma_f32_16x16x32_bf16 v[116:119], a[44:47], a[108:111], v[116:119]
    s_waitcnt vmcnt(22)
    ds_read_b128 a[112:115], v13 offset:8192
    ds_read_b128 a[116:119], v14 offset:8192
    ds_read_b128 a[120:123], v15 offset:8192
    ds_read_b128 a[124:127], v16 offset:8192
    s_nop 2
    v_cvt_pk_bf16_f32 v73, v114, v115
    v_cvt_pk_bf16_f32 v77, v116, v117
    v_cvt_pk_bf16_f32 v81, v118, v119
    v_perm_b32 v73, v77, v73, v19
    v_perm_b32 v86, v81, v73, v20
    v_perm_b32 v87, v81, v73, v21
    v_mul_f32 v86, s42, v86
    v_mul_f32 v87, s42, v87
    v_cvt_pk_bf16_f32 v29, v86, v87
    s_waitcnt lgkmcnt(3)
    v_mfma_f32_16x16x32_bf16 v[120:123], a[32:35], a[112:115], 0
    v_mfma_f32_16x16x32_bf16 v[124:127], a[48:51], a[112:115], 0
    s_waitcnt lgkmcnt(2)
    v_mfma_f32_16x16x32_bf16 v[120:123], a[36:39], a[116:119], v[120:123]
    v_mfma_f32_16x16x32_bf16 v[124:127], a[52:55], a[116:119], v[124:127]
    s_waitcnt lgkmcnt(1)
    v_mfma_f32_16x16x32_bf16 v[120:123], a[40:43], a[120:123], v[120:123]
    v_mfma_f32_16x16x32_bf16 v[124:127], a[56:59], a[120:123], v[124:127]
    s_waitcnt lgkmcnt(0)
    v_mfma_f32_16x16x32_bf16 v[120:123], a[44:47], a[124:127], v[120:123]
    v_mfma_f32_16x16x32_bf16 v[124:127], a[60:63], a[124:127], v[124:127]
    s_waitcnt vmcnt(18)
    ds_read_b128 a[128:131], v13 offset:12288
    ds_read_b128 a[132:135], v14 offset:12288
    ds_read_b128 a[136:139], v15 offset:12288
    ds_read_b128 a[140:143], v16 offset:12288
    s_nop 2
    v_cvt_pk_bf16_f32 v74, v122, v123
    v_cvt_pk_bf16_f32 v78, v124, v125
    v_cvt_pk_bf16_f32 v82, v126, v127
    v_perm_b32 v74, v78, v74, v19
    v_perm_b32 v88, v82, v74, v20
    v_perm_b32 v89, v82, v74, v21
    v_mul_f32 v88, s42, v88
    v_mul_f32 v89, s42, v89
    v_cvt_pk_bf16_f32 v30, v88, v89
    s_waitcnt lgkmcnt(3)
    v_mfma_f32_16x16x32_bf16 v[128:131], a[48:51], a[128:131], 0
    v_mfma_f32_16x16x32_bf16 v[132:135], a[64:67], a[128:131], 0
    s_waitcnt lgkmcnt(2)
    v_mfma_f32_16x16x32_bf16 v[128:131], a[52:55], a[132:135], v[128:131]
    v_mfma_f32_16x16x32_bf16 v[132:135], a[68:71], a[132:135], v[132:135]
    s_waitcnt lgkmcnt(1)
    v_mfma_f32_16x16x32_bf16 v[128:131], a[56:59], a[136:139], v[128:131]
    v_mfma_f32_16x16x32_bf16 v[132:135], a[72:75], a[136:139], v[132:135]
    s_waitcnt lgkmcnt(0)
    v_mfma_f32_16x16x32_bf16 v[128:131], a[60:63], a[140:143], v[128:131]
    v_mfma_f32_16x16x32_bf16 v[132:135], a[76:79], a[140:143], v[132:135]
    s_nop 6
    v_cvt_pk_bf16_f32 v75, v130, v131
    v_cvt_pk_bf16_f32 v79, v132, v133
    v_cvt_pk_bf16_f32 v83, v134, v135
    v_perm_b32 v75, v79, v75, v19
    v_perm_b32 v90, v83, v75, v20
    v_perm_b32 v91, v83, v75, v21
    v_mul_f32 v90, s42, v90
    v_mul_f32 v91, s42, v91
    v_cvt_pk_bf16_f32 v31, v90, v91
    s_nop 0
    s_nop 0
    v_permlane32_swap_b32 v29, v31
    v_permlane32_swap_b32 v28, v30
    s_nop 1
    v_permlane16_swap_b32 v30, v31
    v_permlane16_swap_b32 v28, v29
    v_lshlrev_b32 v76, 16, v30
    v_and_b32 v77, s43, v30
    v_lshlrev_b32 v78, 16, v31
    v_and_b32 v79, s43, v31
    v_lshlrev_b32 v72, 16, v28
    v_and_b32 v73, s43, v28
    v_lshlrev_b32 v74, 16, v29
    v_and_b32 v75, s43, v29
    v_max3_f32 v80, v76, v77, v78
    v_max3_f32 v81, v79, v72, v73
    v_max3_f32 v80, v80, v74, v75
    v_max_f32 v80, v80, v81
    v_pk_add_f32 v[72:73], v[72:73], v[80:81] op_sel_hi:[1,0] neg_lo:[0,1] neg_hi:[0,1]
    v_pk_add_f32 v[74:75], v[74:75], v[80:81] op_sel_hi:[1,0] neg_lo:[0,1] neg_hi:[0,1]
    v_pk_add_f32 v[76:77], v[76:77], v[80:81] op_sel_hi:[1,0] neg_lo:[0,1] neg_hi:[0,1]
    v_pk_add_f32 v[78:79], v[78:79], v[80:81] op_sel_hi:[1,0] neg_lo:[0,1] neg_hi:[0,1]
    v_pk_mul_f32 v[72:73], v[72:73], s[44:45]
    v_pk_mul_f32 v[74:75], v[74:75], s[44:45]
    v_pk_mul_f32 v[76:77], v[76:77], s[44:45]
    v_pk_mul_f32 v[78:79], v[78:79], s[44:45]
    v_exp_f32 v72, v72
    v_exp_f32 v73, v73
    v_exp_f32 v74, v74
    v_exp_f32 v75, v75
    v_exp_f32 v76, v76
    v_exp_f32 v77, v77
    v_exp_f32 v78, v78
    v_exp_f32 v79, v79
    v_pk_add_f32 v[80:81], v[72:73], v[74:75]
    v_pk_add_f32 v[82:83], v[76:77], v[78:79]
    v_pk_add_f32 v[80:81], v[80:81], v[82:83]
    v_add_f32 v80, v80, v81
    v_rcp_f32 v80, v80
    s_nop 0
    v_pk_mul_f32 v[72:73], v[72:73], v[80:81] op_sel_hi:[1,0]
    v_pk_mul_f32 v[74:75], v[74:75], v[80:81] op_sel_hi:[1,0]
    v_pk_mul_f32 v[76:77], v[76:77], v[80:81] op_sel_hi:[1,0]
    v_pk_mul_f32 v[78:79], v[78:79], v[80:81] op_sel_hi:[1,0]
    v_cvt_pk_bf16_f32 v29, v74, v75
    v_cvt_pk_bf16_f32 v31, v78, v79
    v_cvt_pk_bf16_f32 v28, v72, v73
    v_cvt_pk_bf16_f32 v30, v76, v77
    s_nop 0
    v_permlane32_swap_b32 v29, v31
    v_permlane32_swap_b32 v28, v30
    s_nop 1
    v_permlane16_swap_b32 v30, v31
    v_permlane16_swap_b32 v28, v29
    s_barrier
    v_perm_b32 v35, v28, v28, v22
    v_perm_b32 v32, v28, v28, v23
    v_perm_b32 v33, v28, v28, v24
    s_waitcnt vmcnt(16)
    v_perm_b32 v43, v140, v136, s40
    v_perm_b32 v47, v140, v136, s41
    v_perm_b32 v51, v141, v137, s40
    v_perm_b32 v55, v141, v137, s41
    v_perm_b32 v59, v142, v138, s40
    v_perm_b32 v63, v142, v138, s41
    v_perm_b32 v67, v143, v139, s40
    v_perm_b32 v71, v143, v139, s41
    s_waitcnt vmcnt(12)
    v_perm_b32 v40, v148, v144, s40
    v_perm_b32 v41, v156, v152, s40
    v_perm_b32 v44, v148, v144, s41
    v_perm_b32 v45, v156, v152, s41
    v_perm_b32 v48, v149, v145, s40
    v_perm_b32 v49, v157, v153, s40
    v_mfma_f32_16x16x32_bf16 v[72:75], v[32:35], v[40:43], 0
    v_perm_b32 v52, v149, v145, s41
    v_perm_b32 v53, v157, v153, s41
    v_mfma_f32_16x16x32_bf16 v[76:79], v[32:35], v[44:47], 0
    v_perm_b32 v56, v150, v146, s40
    v_perm_b32 v57, v158, v154, s40
    v_mfma_f32_16x16x32_bf16 v[80:83], v[32:35], v[48:51], 0
    v_perm_b32 v60, v150, v146, s41
    v_perm_b32 v61, v158, v154, s41
    v_mfma_f32_16x16x32_bf16 v[84:87], v[32:35], v[52:55], 0
    v_perm_b32 v64, v151, v147, s40
    v_perm_b32 v65, v159, v155, s40
    v_mfma_f32_16x16x32_bf16 v[88:91], v[32:35], v[56:59], 0
    v_perm_b32 v68, v151, v147, s41
    v_perm_b32 v69, v159, v155, s41
    v_mfma_f32_16x16x32_bf16 v[92:95], v[32:35], v[60:63], 0
    v_mfma_f32_16x16x32_bf16 v[96:99], v[32:35], v[64:67], 0
    v_mfma_f32_16x16x32_bf16 v[100:103], v[32:35], v[68:71], 0
    v_perm_b32 v37, v29, v29, v22
    v_perm_b32 v38, v29, v29, v23
    v_perm_b32 v39, v29, v29, v24
    s_waitcnt vmcnt(8)
    v_perm_b32 v42, v164, v160, s40
    v_perm_b32 v43, v172, v168, s40
    v_perm_b32 v46, v164, v160, s41
    v_perm_b32 v47, v172, v168, s41
    v_perm_b32 v50, v165, v161, s40
    v_perm_b32 v51, v173, v169, s40
    v_mfma_f32_16x16x32_bf16 v[104:107], v[36:39], v[40:43], 0
    v_perm_b32 v54, v165, v161, s41
    v_perm_b32 v55, v173, v169, s41
    v_cvt_pk_bf16_f32 v144, v72, v76
    v_cvt_pk_bf16_f32 v145, v80, v84
    v_cvt_pk_bf16_f32 v146, v88, v92
    v_mfma_f32_16x16x32_bf16 v[108:111], v[36:39], v[44:47], 0
    v_perm_b32 v58, v166, v162, s40
    v_perm_b32 v59, v174, v170, s40
    v_cvt_pk_bf16_f32 v147, v96, v100
    buffer_store_dwordx4 v[144:147], v5, s[20:23], s26 offen nt
    v_cvt_pk_bf16_f32 v148, v73, v77
    v_mfma_f32_16x16x32_bf16 v[112:115], v[36:39], v[48:51], 0
    v_perm_b32 v62, v166, v162, s41
    v_perm_b32 v63, v174, v170, s41
    v_cvt_pk_bf16_f32 v149, v81, v85
    v_cvt_pk_bf16_f32 v150, v89, v93
    v_cvt_pk_bf16_f32 v151, v97, v101
    v_mfma_f32_16x16x32_bf16 v[116:119], v[36:39], v[52:55], 0
    v_perm_b32 v66, v167, v163, s40
    v_perm_b32 v67, v175, v171, s40
    buffer_store_dwordx4 v[148:151], v6, s[20:23], s26 offen nt
    v_cvt_pk_bf16_f32 v152, v74, v78
    v_cvt_pk_bf16_f32 v153, v82, v86
    v_mfma_f32_16x16x32_bf16 v[120:123], v[36:39], v[56:59], 0
    v_perm_b32 v70, v167, v163, s41
    v_perm_b32 v71, v175, v171, s41
    v_cvt_pk_bf16_f32 v154, v90, v94
    v_cvt_pk_bf16_f32 v155, v98, v102
    buffer_store_dwordx4 v[152:155], v7, s[20:23], s26 offen nt
    v_mfma_f32_16x16x32_bf16 v[124:127], v[36:39], v[60:63], 0
    v_cvt_pk_bf16_f32 v156, v75, v79
    v_cvt_pk_bf16_f32 v157, v83, v87
    v_cvt_pk_bf16_f32 v158, v91, v95
    v_mfma_f32_16x16x32_bf16 v[128:131], v[36:39], v[64:67], 0
    v_cvt_pk_bf16_f32 v159, v99, v103
    buffer_store_dwordx4 v[156:159], v8, s[20:23], s26 offen nt
    v_mfma_f32_16x16x32_bf16 v[132:135], v[36:39], v[68:71], 0
    v_perm_b32 v35, v30, v30, v22
    v_perm_b32 v32, v30, v30, v23
    v_perm_b32 v33, v30, v30, v24
    s_waitcnt vmcnt(8)
    v_perm_b32 v40, v180, v176, s40
    v_perm_b32 v41, v188, v184, s40
    v_perm_b32 v44, v180, v176, s41
    v_perm_b32 v45, v188, v184, s41
    v_perm_b32 v48, v181, v177, s40
    v_perm_b32 v49, v189, v185, s40
    v_mfma_f32_16x16x32_bf16 v[72:75], v[32:35], v[40:43], 0
    v_perm_b32 v52, v181, v177, s41
    v_perm_b32 v53, v189, v185, s41
    v_cvt_pk_bf16_f32 v160, v104, v108
    v_cvt_pk_bf16_f32 v161, v112, v116
    v_cvt_pk_bf16_f32 v162, v120, v124
    v_mfma_f32_16x16x32_bf16 v[76:79], v[32:35], v[44:47], 0
    v_perm_b32 v56, v182, v178, s40
    v_perm_b32 v57, v190, v186, s40
    v_cvt_pk_bf16_f32 v163, v128, v132
    buffer_store_dwordx4 v[160:163], v5, s[20:23], s27 offen nt
    v_cvt_pk_bf16_f32 v164, v105, v109
    v_mfma_f32_16x16x32_bf16 v[80:83], v[32:35], v[48:51], 0
    v_perm_b32 v60, v182, v178, s41
    v_perm_b32 v61, v190, v186, s41
    v_cvt_pk_bf16_f32 v165, v113, v117
    v_cvt_pk_bf16_f32 v166, v121, v125
    v_cvt_pk_bf16_f32 v167, v129, v133
    v_mfma_f32_16x16x32_bf16 v[84:87], v[32:35], v[52:55], 0
    v_perm_b32 v64, v183, v179, s40
    v_perm_b32 v65, v191, v187, s40
    buffer_store_dwordx4 v[164:167], v6, s[20:23], s27 offen nt
    v_cvt_pk_bf16_f32 v168, v106, v110
    v_cvt_pk_bf16_f32 v169, v114, v118
    v_mfma_f32_16x16x32_bf16 v[88:91], v[32:35], v[56:59], 0
    v_perm_b32 v68, v183, v179, s41
    v_perm_b32 v69, v191, v187, s41
    v_cvt_pk_bf16_f32 v170, v122, v126
    v_cvt_pk_bf16_f32 v171, v130, v134
    buffer_store_dwordx4 v[168:171], v7, s[20:23], s27 offen nt
    v_mfma_f32_16x16x32_bf16 v[92:95], v[32:35], v[60:63], 0
    v_cvt_pk_bf16_f32 v172, v107, v111
    v_cvt_pk_bf16_f32 v173, v115, v119
    v_cvt_pk_bf16_f32 v174, v123, v127
    v_mfma_f32_16x16x32_bf16 v[96:99], v[32:35], v[64:67], 0
    v_cvt_pk_bf16_f32 v175, v131, v135
    buffer_store_dwordx4 v[172:175], v8, s[20:23], s27 offen nt
    v_mfma_f32_16x16x32_bf16 v[100:103], v[32:35], v[68:71], 0
    v_perm_b32 v37, v31, v31, v22
    v_perm_b32 v38, v31, v31, v23
    v_perm_b32 v39, v31, v31, v24
    s_nop 4
    v_cvt_pk_bf16_f32 v176, v72, v76
    v_cvt_pk_bf16_f32 v177, v80, v84
    v_cvt_pk_bf16_f32 v178, v88, v92
    v_cvt_pk_bf16_f32 v179, v96, v100
    buffer_store_dwordx4 v[176:179], v5, s[20:23], s28 offen nt
    v_cvt_pk_bf16_f32 v180, v73, v77
    v_cvt_pk_bf16_f32 v181, v81, v85
    v_cvt_pk_bf16_f32 v182, v89, v93
    v_cvt_pk_bf16_f32 v183, v97, v101
    buffer_store_dwordx4 v[180:183], v6, s[20:23], s28 offen nt
    v_cvt_pk_bf16_f32 v184, v74, v78
    v_cvt_pk_bf16_f32 v185, v82, v86
    v_cvt_pk_bf16_f32 v186, v90, v94
    v_cvt_pk_bf16_f32 v187, v98, v102
    buffer_store_dwordx4 v[184:187], v7, s[20:23], s28 offen nt
    v_cvt_pk_bf16_f32 v188, v75, v79
    v_cvt_pk_bf16_f32 v189, v83, v87
    v_cvt_pk_bf16_f32 v190, v91, v95
    v_cvt_pk_bf16_f32 v191, v99, v103
    buffer_store_dwordx4 v[188:191], v8, s[20:23], s28 offen nt
    s_waitcnt vmcnt(12)
    v_perm_b32 v42, v196, v192, s40
    v_perm_b32 v43, v204, v200, s40
    v_perm_b32 v46, v196, v192, s41
    v_perm_b32 v47, v204, v200, s41
    v_perm_b32 v50, v197, v193, s40
    v_perm_b32 v51, v205, v201, s40
    v_mfma_f32_16x16x32_bf16 v[104:107], v[36:39], v[40:43], 0
    v_perm_b32 v54, v197, v193, s41
    v_perm_b32 v55, v205, v201, s41
    v_mfma_f32_16x16x32_bf16 v[108:111], v[36:39], v[44:47], 0
    v_perm_b32 v58, v198, v194, s40
    v_perm_b32 v59, v206, v202, s40
    v_mfma_f32_16x16x32_bf16 v[112:115], v[36:39], v[48:51], 0
    v_perm_b32 v62, v198, v194, s41
    v_perm_b32 v63, v206, v202, s41
    v_mfma_f32_16x16x32_bf16 v[116:119], v[36:39], v[52:55], 0
    v_perm_b32 v66, v199, v195, s40
    v_perm_b32 v67, v207, v203, s40
    v_mfma_f32_16x16x32_bf16 v[120:123], v[36:39], v[56:59], 0
    v_perm_b32 v70, v199, v195, s41
    v_perm_b32 v71, v207, v203, s41
    v_mfma_f32_16x16x32_bf16 v[124:127], v[36:39], v[60:63], 0
    v_mfma_f32_16x16x32_bf16 v[128:131], v[36:39], v[64:67], 0
    v_mfma_f32_16x16x32_bf16 v[132:135], v[36:39], v[68:71], 0
    s_nop 7
    v_cvt_pk_bf16_f32 v192, v104, v108
    v_cvt_pk_bf16_f32 v193, v112, v116
    v_cvt_pk_bf16_f32 v194, v120, v124
    v_cvt_pk_bf16_f32 v195, v128, v132
    buffer_store_dwordx4 v[192:195], v5, s[20:23], s29 offen nt
    v_cvt_pk_bf16_f32 v196, v105, v109
    v_cvt_pk_bf16_f32 v197, v113, v117
    v_cvt_pk_bf16_f32 v198, v121, v125
    v_cvt_pk_bf16_f32 v199, v129, v133
    buffer_store_dwordx4 v[196:199], v6, s[20:23], s29 offen nt
    v_cvt_pk_bf16_f32 v200, v106, v110
    v_cvt_pk_bf16_f32 v201, v114, v118
    v_cvt_pk_bf16_f32 v202, v122, v126
    v_cvt_pk_bf16_f32 v203, v130, v134
    buffer_store_dwordx4 v[200:203], v7, s[20:23], s29 offen nt
    v_cvt_pk_bf16_f32 v204, v107, v111
    v_cvt_pk_bf16_f32 v205, v115, v119
    v_cvt_pk_bf16_f32 v206, v123, v127
    v_cvt_pk_bf16_f32 v207, v131, v135
    buffer_store_dwordx4 v[204:207], v8, s[20:23], s29 offen nt
L_done:
    s_endpgm
.section .rodata,"a"
.p2align 6
.amdhsa_kernel standalone__sliding_local_strided__prompt_kernel
  .amdhsa_next_free_vgpr 352
  .amdhsa_next_free_sgpr 48
  .amdhsa_accum_offset 208
  .amdhsa_group_segment_fixed_size 0
  .amdhsa_kernarg_size 48
  .amdhsa_user_sgpr_count 2
  .amdhsa_user_sgpr_kernarg_segment_ptr 1
  .amdhsa_system_sgpr_workgroup_id_x 1
.end_amdhsa_kernel
```
